```python
import torch

def _softmax(x, axis=-1):
    return torch.softmax(x, dim=axis)

def _gelu(x):
    return torch.nn.functional.gelu(x, approximate='tanh')

def _silu(x):
    return torch.nn.functional.silu(x)

def _sigmoid(x):
    return torch.sigmoid(x)

def _layernorm(x, axis=-1, eps=1e-05):
    m = x.mean(dim=axis, keepdim=True)
    v = x.var(dim=axis, keepdim=True, unbiased=False)
    return (x - m) / torch.sqrt(v + eps)

def _scatter_add(tgt, idx, src, axis=0):
    return tgt.clone().index_add_(axis, idx, src)

def _segment_sum(src, seg, n):
    out = torch.zeros((n,) + src.shape[1:], dtype=src.dtype)
    return out.index_add_(0, seg, src)

def _pad(x, pw):
    flat = tuple((v for pair in reversed(pw) for v in pair))
    return torch.nn.functional.pad(x, flat)
kernel_name = 'standalone__autoregressive_conv_wavernn__speech'

def setup_inputs():

    _w = lambda a: (lambda t: t.to(torch.bfloat16) if t.is_floating_point() else t)(torch.as_tensor(a))
    B, T, D, K = (2, 4000, 256, 3)
    return {'x': _w((lambda *s: torch.randn(*s, dtype=torch.bfloat16) * 0.1)(B, T, D)), 'w': _w((lambda *s: torch.randn(*s, dtype=torch.bfloat16) * 0.1)(K, D, 2 * D))}

def reference(x, w):
    B, T, D = x.shape
    K = w.shape[0]
    dil = 2
    pad = (K - 1) * dil
    xp = _pad(x, ((0, 0), (pad, 0), (0, 0)))
    h = torch.einsum('btd,de->bte', xp[:, 0:T, :], w[0])
    for i in range(1, K):
        h = h + torch.einsum('btd,de->bte', xp[:, i * dil:i * dil + T, :], w[i])
    f, g = (h[..., :D].clone(), h[..., D:].clone())
    return torch.tanh(f) * _sigmoid(g)
```

```asm
; @launch grid=(256,1,1) block=(256,1,1) lds=160768
.amdgcn_target "amdgcn-amd-amdhsa--gfx950"
.text
.p2align 12
.globl standalone__autoregressive_conv_wavernn__speech_kernel
.p2align 8
.type standalone__autoregressive_conv_wavernn__speech_kernel,@function
standalone__autoregressive_conv_wavernn__speech_kernel:
    s_load_dwordx4 s[4:7], s[0:1], 0
    s_cmpk_ge_u32 s2, 256
    s_cbranch_scc1 L_end
    s_getpc_b64 s[10:11]
L_pc:
    v_lshlrev_b32 v22, 7, v0
    v_mov_b32 v23, 0
    v_min_u32 v22, L_end-L_pc, v22
    v_lshl_add_u64 v[22:23], v[22:23], 0, s[10:11]
    global_load_dword v21, v[22:23], off
    v_lshrrev_b32 v1, 6, v0
    v_and_b32 v0, 63, v0
    v_readfirstlane_b32 s32, v1
    s_lshr_b32 s36, s2, 3
    s_lshr_b32 s37, s2, 5
    s_and_b32 s34, s36, 3
    s_add_u32 s36, s36, s37
    s_lshl2_add_u32 s41, s36, s2
    s_lshr_b32 s38, s2, 6
    s_lshr_b32 s36, 8, s34
    s_and_b32 s38, s38, s36
    s_and_b32 s38, s38, 1
    s_xor_b32 s41, s41, s38
    s_and_b32 s38, s41, 7
    s_lshl_b32 s52, s38, 15
    s_and_b32 s38, s41, 6
    s_lshl_b32 s48, s38, 6
    s_and_b32 s41, s41, 1
    s_and_b32 s36, s2, 3
    s_lshl3_add_u32 s33, s36, s37
    s_mulk_i32 s33, 125
    s_bitcmp1_b32 s2, 2
    s_cselect_b32 s35, 2048000, 0
    s_lshl_b32 s34, s34, 7
    v_lshrrev_b32 v24, 3, v0
    v_and_b32 v25, 7, v0
    v_and_b32 v26, 6, v24
    v_xor_b32 v26, v26, v25
    v_lshlrev_b32 v26, 4, v26
    s_lshl3_add_u32 s36, s32, s33
    s_sub_u32 s36, s36, 4
    v_add_u32 v27, s36, v24
    v_lshl_add_u32 v2, v27, 9, v26
    s_lshl_b32 s40, s32, 10
    s_mov_b32 s14, 2048000
    s_mov_b32 s15, 0x20000
    s_mov_b32 m0, s40
    s_waitcnt lgkmcnt(0)
    s_add_u32 s12, s4, s35
    s_addc_u32 s13, s5, 0
    buffer_load_dwordx4 v2, s[12:15], s48 offen lds
    s_add_u32 m0, s40, 4096
    s_movk_i32 s37, 0x4000
    v_add_u32 v3, s37, v2
    v_add_u32 v4, s37, v3
    v_add_u32 v5, s37, v4
    v_and_b32 v28, 2, v24
    s_and_b32 s36, s32, 1
    s_lshl_b32 s36, s36, 2
    s_mov_b64 s[20:21], s[6:7]
    buffer_load_dwordx4 v3, s[12:15], s48 offen lds
    s_add_u32 m0, s40, 8192
    v_or_b32 v28, s36, v28
    v_xor_b32 v28, v28, v25
    v_lshlrev_b32 v28, 4, v28
    v_lshl_add_u32 v28, v24, 10, v28
    s_lshl_b32 s36, s32, 13
    s_add_u32 s36, s36, s34
    s_mul_i32 s39, s40, 3
    s_add_u32 s24, s6, 261120
    s_addc_u32 s25, s7, 0
    buffer_load_dwordx4 v4, s[12:15], s48 offen lds
    s_add_u32 m0, s39, 69632
    v_add_u32 v7, s36, v28
    v_add_u32 v8, 512, v7
    s_mov_b32 s22, 264192
    s_mov_b32 s23, s15
    s_mov_b64 s[26:27], s[22:23]
    s_mov_b64 s[30:31], s[22:23]
    s_xor_b32 s53, s52, 0x8000
    s_add_u32 s28, s6, 522240
    s_addc_u32 s29, s7, 0
    buffer_load_dwordx4 v7, s[20:23], s52 offen lds
    buffer_load_dwordx4 v7, s[24:27], s52 offen offset:1024 lds
    buffer_load_dwordx4 v7, s[28:31], s52 offen offset:2048 lds
    s_add_u32 m0, s39, 81920
    s_load_dwordx2 s[8:9], s[0:1], 16
    buffer_load_dwordx4 v8, s[20:23], s52 offen lds
    buffer_load_dwordx4 v8, s[24:27], s52 offen offset:1024 lds
    buffer_load_dwordx4 v8, s[28:31], s52 offen offset:2048 lds
    s_add_u32 s36, s52, 131072
    s_and_b32 s54, s36, 0x3ffff
    s_xor_b32 s55, s54, 0x8000
    s_lshr_b32 s36, s54, 16
    s_lshl_b32 s49, s36, 7
    s_add_u32 s36, s52, 65536
    s_and_b32 s56, s36, 0x3ffff
    s_xor_b32 s57, s56, 0x8000
    s_lshr_b32 s36, s56, 16
    s_lshl_b32 s50, s36, 7
    s_add_u32 s36, s52, 196608
    s_and_b32 s58, s36, 0x3ffff
    s_xor_b32 s59, s58, 0x8000
    s_lshr_b32 s36, s58, 16
    s_lshl_b32 s51, s36, 7
    s_add_u32 s36, s33, 124
    s_lshl_b32 s36, s36, 9
    v_cmp_gt_u32 vcc, 32, v0
    v_lshl_add_u32 v26, v0, 2, s36
    v_bfrev_b32 v27, 1
    v_cndmask_b32 v6, v27, v26, vcc
    s_mul_i32 s60, s40, 17
    s_bitcmp1_b32 s32, 0
    s_cselect_b32 s36, s49, s48
    s_cselect_b32 s61, s51, s50
    s_bitcmp1_b32 s32, 1
    s_cselect_b32 s61, s61, s36
    v_lshrrev_b32 v96, 4, v0
    v_mul_u32_u24 v98, 3072, v96
    v_bfe_u32 v97, v0, 2, 2
    v_lshl_add_u32 v98, v97, 7, v98
    v_and_b32 v99, 3, v0
    v_lshl_add_u32 v98, v99, 3, v98
    v_and_b32 v97, 3, v24
    v_xor_b32 v97, s32, v97
    v_lshl_add_u32 v98, v97, 5, v98
    v_add_u32 v9, 69632, v98
    v_add_u32 v10, 131072, v98
    v_and_b32 v100, 1, v24
    s_lshl_b32 s36, s41, 2
    v_xor_b32 v101, s36, v96
    v_mad_u32_u24 v98, v25, 10, v100
    v_and_b32 v99, 6, v98
    v_xor_b32 v99, v99, v101
    v_lshlrev_b32 v99, 4, v99
    v_lshl_add_u32 v13, v98, 7, v99
    v_xor_b32 v15, 64, v13
    v_add_u32 v99, 2, v98
    v_and_b32 v99, 6, v99
    v_xor_b32 v99, v99, v101
    v_lshlrev_b32 v99, 4, v99
    v_lshl_add_u32 v14, v98, 7, v99
    v_xor_b32 v16, 64, v14
    v_mad_u32_u24 v98, v25, 6, v100
    v_add_u32 v98, 80, v98
    v_and_b32 v99, 6, v98
    v_xor_b32 v99, v99, v101
    v_lshlrev_b32 v99, 4, v99
    v_lshl_add_u32 v17, v98, 7, v99
    v_xor_b32 v19, 64, v17
    v_add_u32 v99, 2, v98
    v_and_b32 v99, 6, v99
    v_xor_b32 v99, v99, v101
    v_lshlrev_b32 v99, 4, v99
    v_lshl_add_u32 v18, v98, 7, v99
    v_xor_b32 v20, 64, v18
    s_lshl_b32 s36, s32, 1
    v_lshrrev_b32 v26, 5, v0
    v_add_u32 v26, s36, v26
    v_xor_b32 v26, v26, v25
    v_lshlrev_b32 v26, 4, v26
    v_and_b32 v27, 15, v0
    v_lshl_add_u32 v26, v27, 7, v26
    v_and_b32 v27, 1, v96
    v_lshl_add_u32 v26, v27, 3, v26
    v_add_u32 v11, 143360, v26
    s_mov_b32 s37, 159744
    v_lshl_add_u32 v26, v0, 2, s37
    s_lshl_b32 s36, s32, 8
    v_add_u32 v211, s36, v26
    v_lshl_add_u32 v212, v96, 8, v26
    v_mov_b32 v216, 0
    v_mov_b32 v217, 1
    v_mov_b32 v218, 2
    v_mov_b32 v219, 3
    ds_write_b32 v211, v216
    v_lshl_add_u32 v29, v0, 2, s60
    ds_write_b32 v29, v216 offset:16640
    v_xor_b32 v26, v24, v25
    v_lshlrev_b32 v26, 4, v26
    v_lshl_add_u32 v26, v24, 7, v26
    s_add_u32 s36, s40, 143360
    v_add_u32 v12, s36, v26
    s_add_u32 s38, s33, s32
    s_lshl_b32 s38, s38, 9
    s_add_u32 s38, s38, s34
    v_lshl_add_u32 v28, v25, 4, s38
    v_mul_u32_u24 v26, 5120, v24
    v_add_u32 v208, v26, v28
    v_mul_u32_u24 v27, 3072, v24
    v_add_u32 v27, v27, v28
    v_add_u32 v210, 41984, v27
    s_cmp_lt_u32 s32, 2
    s_cselect_b64 vcc, -1, 0
    v_add_u32 v26, 4096, v208
    v_add_u32 v27, 39936, v27
    v_cndmask_b32 v209, v27, v26, vcc
    s_add_u32 s18, s33, 125
    s_lshl_b32 s18, s18, 9
    s_mov_b32 s19, s15
    s_mov_b32 s44, 0x4038aa3b
    s_mov_b32 s45, s44
    s_mov_b32 s46, 0xbfb8aa3b
    s_mov_b32 s47, s46
    s_mov_b32 s43, 0x41f00000
    s_waitcnt lgkmcnt(0)
    s_add_u32 s16, s8, s35
    s_addc_u32 s17, s9, 0
    s_cmp_eq_u32 0, 0
    s_branch L_pick
    .p2align 12
    .fill 211, 4, 0xbf810000
L_w0:
    s_add_u32 m0, s39, 94208
    s_nop 0
    buffer_load_dwordx4 v7, s[20:23], s53 offen lds
    buffer_load_dwordx4 v7, s[24:27], s53 offen offset:1024 lds
    buffer_load_dwordx4 v7, s[28:31], s53 offen offset:2048 lds
    s_add_u32 m0, s40, 17408
    s_nop 0
    buffer_load_dwordx4 v2, s[12:15], s49 offen lds
    s_add_u32 m0, s40, 21504
    s_nop 0
    buffer_load_dwordx4 v3, s[12:15], s49 offen lds
    s_add_u32 m0, s40, 25600
    s_nop 0
    buffer_load_dwordx4 v4, s[12:15], s49 offen lds
    s_add_u32 m0, s39, 106496
    s_nop 0
    buffer_load_dwordx4 v8, s[20:23], s53 offen lds
    buffer_load_dwordx4 v8, s[24:27], s53 offen offset:1024 lds
    buffer_load_dwordx4 v8, s[28:31], s53 offen offset:2048 lds
    s_waitcnt vmcnt(12)
    s_barrier
    ds_read_b64_tr_b16 a[0:1], v9 offset:0
    ds_read_b64_tr_b16 a[2:3], v9 offset:512
    ds_read_b128 v[96:99], v13 offset:0
    ds_read_b64_tr_b16 a[4:5], v9 offset:1024
    ds_read_b64_tr_b16 a[6:7], v9 offset:1536
    ds_read_b128 v[100:103], v14 offset:256
    ds_read_b64_tr_b16 a[8:9], v9 offset:2048
    ds_read_b64_tr_b16 a[10:11], v9 offset:2560
    ds_read_b128 v[104:107], v15 offset:512
    ds_read_b128 v[108:111], v16 offset:768
    s_waitcnt lgkmcnt(7)
    v_mfma_f32_16x16x32_bf16 v[32:35], a[0:3], v[96:99], 0
    s_waitcnt lgkmcnt(4)
    s_add_u32 m0, s39, 118784
    s_nop 0
    buffer_load_dwordx4 v7, s[20:23], s54 offen lds
    v_mfma_f32_16x16x32_bf16 v[32:35], a[4:7], v[100:103], v[32:35]
    s_waitcnt lgkmcnt(1)
    ds_read_b128 v[112:115], v13 offset:1024
    v_mfma_f32_16x16x32_bf16 v[32:35], a[8:11], v[104:107], v[32:35]
    ds_read_b128 v[116:119], v14 offset:1280
    v_mfma_f32_16x16x32_bf16 v[40:43], a[0:3], v[100:103], 0
    ds_read_b128 v[120:123], v15 offset:1536
    v_mfma_f32_16x16x32_bf16 v[40:43], a[4:7], v[104:107], v[40:43]
    s_waitcnt lgkmcnt(3) vmcnt(10)
    buffer_load_dwordx4 v7, s[24:27], s54 offen offset:1024 lds
    v_mfma_f32_16x16x32_bf16 v[40:43], a[8:11], v[108:111], v[40:43]
    s_barrier
    ds_read_b64_tr_b16 a[12:13], v9 offset:12288
    v_mfma_f32_16x16x32_bf16 v[48:51], a[0:3], v[104:107], 0
    ds_read_b64_tr_b16 a[14:15], v9 offset:12800
    v_mfma_f32_16x16x32_bf16 v[48:51], a[4:7], v[108:111], v[48:51]
    s_waitcnt lgkmcnt(4)
    ds_read_b64_tr_b16 a[16:17], v9 offset:13312
    v_mfma_f32_16x16x32_bf16 v[48:51], a[8:11], v[112:115], v[48:51]
    buffer_load_dwordx4 v7, s[28:31], s54 offen offset:2048 lds
    v_mfma_f32_16x16x32_bf16 v[56:59], a[0:3], v[108:111], 0
    s_add_u32 m0, s39, 131072
    ds_read_b64_tr_b16 a[18:19], v9 offset:13824
    v_mfma_f32_16x16x32_bf16 v[56:59], a[4:7], v[112:115], v[56:59]
    s_waitcnt lgkmcnt(4)
    ds_read_b64_tr_b16 a[20:21], v9 offset:14336
    v_mfma_f32_16x16x32_bf16 v[56:59], a[8:11], v[116:119], v[56:59]
    ds_read_b64_tr_b16 a[22:23], v9 offset:14848
    v_mfma_f32_16x16x32_bf16 v[64:67], a[0:3], v[112:115], 0
    buffer_load_dwordx4 v8, s[20:23], s54 offen lds
    v_mfma_f32_16x16x32_bf16 v[64:67], a[4:7], v[116:119], v[64:67]
    ds_read_b128 v[136:139], v15 offset:0
    v_mfma_f32_16x16x32_bf16 v[64:67], a[8:11], v[120:123], v[64:67]
    s_waitcnt lgkmcnt(5)
    ds_read_b128 v[140:143], v16 offset:256
    v_mfma_f32_16x16x32_bf16 v[36:39], a[12:15], v[96:99], 0
    s_waitcnt lgkmcnt(4)
    ds_read_b128 v[144:147], v13 offset:512
    v_mfma_f32_16x16x32_bf16 v[36:39], a[16:19], v[100:103], v[36:39]
    s_waitcnt lgkmcnt(3)
    buffer_load_dwordx4 v8, s[24:27], s54 offen offset:1024 lds
    v_mfma_f32_16x16x32_bf16 v[36:39], a[20:23], v[104:107], v[36:39]
    ds_read_b128 v[148:151], v14 offset:768
    v_mfma_f32_16x16x32_bf16 v[44:47], a[12:15], v[100:103], 0
    ds_read_b128 v[152:155], v15 offset:1024
    v_mfma_f32_16x16x32_bf16 v[44:47], a[16:19], v[104:107], v[44:47]
    s_waitcnt vmcnt(11)
    ds_read_b128 v[156:159], v16 offset:1280
    v_mfma_f32_16x16x32_bf16 v[44:47], a[20:23], v[108:111], v[44:47]
    s_barrier
    ds_read_b64_tr_b16 a[24:25], v9 offset:24576
    v_mfma_f32_16x16x32_bf16 v[52:55], a[12:15], v[104:107], 0
    buffer_load_dwordx4 v8, s[28:31], s54 offen offset:2048 lds
    v_mfma_f32_16x16x32_bf16 v[52:55], a[16:19], v[108:111], v[52:55]
    s_add_u32 m0, s39, 69632
    ds_read_b64_tr_b16 a[26:27], v9 offset:25088
    v_mfma_f32_16x16x32_bf16 v[52:55], a[20:23], v[112:115], v[52:55]
    ds_read_b64_tr_b16 a[28:29], v9 offset:25600
    v_mfma_f32_16x16x32_bf16 v[60:63], a[12:15], v[108:111], 0
    buffer_load_dwordx4 v7, s[20:23], s55 offen lds
    v_mfma_f32_16x16x32_bf16 v[60:63], a[16:19], v[112:115], v[60:63]
    ds_read_b64_tr_b16 a[30:31], v9 offset:26112
    v_mfma_f32_16x16x32_bf16 v[60:63], a[20:23], v[116:119], v[60:63]
    ds_read_b64_tr_b16 a[32:33], v9 offset:26624
    v_mfma_f32_16x16x32_bf16 v[68:71], a[12:15], v[112:115], 0
    ds_read_b64_tr_b16 a[34:35], v9 offset:27136
    v_mfma_f32_16x16x32_bf16 v[68:71], a[16:19], v[116:119], v[68:71]
    buffer_load_dwordx4 v7, s[24:27], s55 offen offset:1024 lds
    v_mfma_f32_16x16x32_bf16 v[68:71], a[20:23], v[120:123], v[68:71]
    s_waitcnt lgkmcnt(4)
    ds_read_b128 v[160:163], v13 offset:1536
    v_mfma_f32_16x16x32_bf16 v[32:35], a[24:27], v[136:139], v[32:35]
    s_waitcnt lgkmcnt(3)
    v_mfma_f32_16x16x32_bf16 v[32:35], a[28:31], v[140:143], v[32:35]
    s_waitcnt lgkmcnt(1)
    v_mfma_f32_16x16x32_bf16 v[32:35], a[32:35], v[144:147], v[32:35]
    buffer_load_dwordx4 v7, s[28:31], s55 offen offset:2048 lds
    v_mfma_f32_16x16x32_bf16 v[40:43], a[24:27], v[140:143], v[40:43]
    s_add_u32 m0, s40, 34816
    v_mfma_f32_16x16x32_bf16 v[40:43], a[28:31], v[144:147], v[40:43]
    s_waitcnt vmcnt(9)
    v_mfma_f32_16x16x32_bf16 v[40:43], a[32:35], v[148:151], v[40:43]
    s_barrier
    ds_read_b64_tr_b16 a[36:37], v9 offset:36864
    v_mfma_f32_16x16x32_bf16 v[48:51], a[24:27], v[144:147], v[48:51]
    buffer_load_dwordx4 v2, s[12:15], s50 offen lds
    v_mfma_f32_16x16x32_bf16 v[48:51], a[28:31], v[148:151], v[48:51]
    s_add_u32 m0, s40, 38912
    ds_read_b64_tr_b16 a[38:39], v9 offset:37376
    v_mfma_f32_16x16x32_bf16 v[48:51], a[32:35], v[152:155], v[48:51]
    ds_read_b64_tr_b16 a[40:41], v9 offset:37888
    v_mfma_f32_16x16x32_bf16 v[56:59], a[24:27], v[148:151], v[56:59]
    ds_read_b64_tr_b16 a[42:43], v9 offset:38400
    v_mfma_f32_16x16x32_bf16 v[56:59], a[28:31], v[152:155], v[56:59]
    buffer_load_dwordx4 v3, s[12:15], s50 offen lds
    v_mfma_f32_16x16x32_bf16 v[56:59], a[32:35], v[156:159], v[56:59]
    s_add_u32 m0, s40, 43008
    ds_read_b64_tr_b16 a[44:45], v9 offset:38912
    v_mfma_f32_16x16x32_bf16 v[64:67], a[24:27], v[152:155], v[64:67]
    ds_read_b64_tr_b16 a[46:47], v9 offset:39424
    v_mfma_f32_16x16x32_bf16 v[64:67], a[28:31], v[156:159], v[64:67]
    s_waitcnt lgkmcnt(6)
    ds_read_b128 v[96:99], v13 offset:17408
    v_mfma_f32_16x16x32_bf16 v[64:67], a[32:35], v[160:163], v[64:67]
    s_waitcnt lgkmcnt(5)
    buffer_load_dwordx4 v4, s[12:15], s50 offen lds
    v_mfma_f32_16x16x32_bf16 v[36:39], a[36:39], v[136:139], v[36:39]
    s_waitcnt lgkmcnt(3)
    ds_read_b128 v[100:103], v14 offset:17664
    v_mfma_f32_16x16x32_bf16 v[36:39], a[40:43], v[140:143], v[36:39]
    s_waitcnt lgkmcnt(2)
    ds_read_b128 v[104:107], v15 offset:17920
    v_mfma_f32_16x16x32_bf16 v[36:39], a[44:47], v[144:147], v[36:39]
    s_add_u32 m0, s60, 16384
    ds_read_b128 v[108:111], v16 offset:18176
    v_mfma_f32_16x16x32_bf16 v[44:47], a[36:39], v[140:143], v[44:47]
    buffer_load_dword v6, s[12:15], s61 offen lds
    v_mfma_f32_16x16x32_bf16 v[44:47], a[40:43], v[144:147], v[44:47]
    s_waitcnt vmcnt(10)
    ds_read_b128 v[112:115], v13 offset:18432
    v_mfma_f32_16x16x32_bf16 v[44:47], a[44:47], v[148:151], v[44:47]
    s_barrier
    ds_read_b64_tr_b16 a[48:49], v9 offset:49152
    v_mfma_f32_16x16x32_bf16 v[52:55], a[36:39], v[144:147], v[52:55]
    s_add_u32 m0, s39, 81920
    ds_read_b64_tr_b16 a[50:51], v9 offset:49664
    v_mfma_f32_16x16x32_bf16 v[52:55], a[40:43], v[148:151], v[52:55]
    buffer_load_dwordx4 v8, s[20:23], s55 offen lds
    v_mfma_f32_16x16x32_bf16 v[52:55], a[44:47], v[152:155], v[52:55]
    ds_read_b64_tr_b16 a[52:53], v9 offset:50176
    v_mfma_f32_16x16x32_bf16 v[60:63], a[36:39], v[148:151], v[60:63]
    ds_read_b64_tr_b16 a[54:55], v9 offset:50688
    v_mfma_f32_16x16x32_bf16 v[60:63], a[40:43], v[152:155], v[60:63]
    ds_read_b64_tr_b16 a[56:57], v9 offset:51200
    v_mfma_f32_16x16x32_bf16 v[60:63], a[44:47], v[156:159], v[60:63]
    buffer_load_dwordx4 v8, s[24:27], s55 offen offset:1024 lds
    v_mfma_f32_16x16x32_bf16 v[68:71], a[36:39], v[152:155], v[68:71]
    ds_read_b64_tr_b16 a[58:59], v9 offset:51712
    v_mfma_f32_16x16x32_bf16 v[68:71], a[40:43], v[156:159], v[68:71]
    ds_read_b128 v[116:119], v14 offset:18688
    v_mfma_f32_16x16x32_bf16 v[68:71], a[44:47], v[160:163], v[68:71]
    s_waitcnt lgkmcnt(5)
    ds_read_b128 v[120:123], v15 offset:18944
    v_mfma_f32_16x16x32_bf16 v[32:35], a[48:51], v[96:99], v[32:35]
    s_waitcnt lgkmcnt(4)
    buffer_load_dwordx4 v8, s[28:31], s55 offen offset:2048 lds
    v_mfma_f32_16x16x32_bf16 v[32:35], a[52:55], v[100:103], v[32:35]
    s_waitcnt lgkmcnt(2)
    ds_read_b128 v[136:139], v15 offset:17408
    v_mfma_f32_16x16x32_bf16 v[32:35], a[56:59], v[104:107], v[32:35]
    s_add_u32 m0, s39, 94208
    ds_read_b128 v[140:143], v16 offset:17664
    v_mfma_f32_16x16x32_bf16 v[40:43], a[48:51], v[100:103], v[40:43]
    ds_read_b128 v[144:147], v13 offset:17920
    v_mfma_f32_16x16x32_bf16 v[40:43], a[52:55], v[104:107], v[40:43]
    s_waitcnt vmcnt(10)
    buffer_load_dwordx4 v7, s[20:23], s56 offen lds
    v_mfma_f32_16x16x32_bf16 v[40:43], a[56:59], v[108:111], v[40:43]
    s_barrier
    ds_read_b64_tr_b16 a[60:61], v10 offset:0
    v_mfma_f32_16x16x32_bf16 v[48:51], a[48:51], v[104:107], v[48:51]
    ds_read_b64_tr_b16 a[62:63], v10 offset:512
    v_mfma_f32_16x16x32_bf16 v[48:51], a[52:55], v[108:111], v[48:51]
    ds_read_b64_tr_b16 a[64:65], v10 offset:1024
    v_mfma_f32_16x16x32_bf16 v[48:51], a[56:59], v[112:115], v[48:51]
    buffer_load_dwordx4 v7, s[24:27], s56 offen offset:1024 lds
    v_mfma_f32_16x16x32_bf16 v[56:59], a[48:51], v[108:111], v[56:59]
    ds_read_b64_tr_b16 a[66:67], v10 offset:1536
    v_mfma_f32_16x16x32_bf16 v[56:59], a[52:55], v[112:115], v[56:59]
    s_waitcnt lgkmcnt(4)
    ds_read_b64_tr_b16 a[68:69], v10 offset:2048
    v_mfma_f32_16x16x32_bf16 v[56:59], a[56:59], v[116:119], v[56:59]
    ds_read_b64_tr_b16 a[70:71], v10 offset:2560
    v_mfma_f32_16x16x32_bf16 v[64:67], a[48:51], v[112:115], v[64:67]
    buffer_load_dwordx4 v7, s[28:31], s56 offen offset:2048 lds
    v_mfma_f32_16x16x32_bf16 v[64:67], a[52:55], v[116:119], v[64:67]
    s_add_u32 m0, s40, 52224
    ds_read_b128 v[148:151], v14 offset:18176
    v_mfma_f32_16x16x32_bf16 v[64:67], a[56:59], v[120:123], v[64:67]
    s_waitcnt lgkmcnt(5)
    ds_read_b128 v[152:155], v15 offset:18432
    v_mfma_f32_16x16x32_bf16 v[36:39], a[60:63], v[96:99], v[36:39]
    s_waitcnt lgkmcnt(4)
    ds_read_b128 v[156:159], v16 offset:18688
    v_mfma_f32_16x16x32_bf16 v[36:39], a[64:67], v[100:103], v[36:39]
    s_waitcnt lgkmcnt(3)
    buffer_load_dwordx4 v2, s[12:15], s51 offen lds
    v_mfma_f32_16x16x32_bf16 v[36:39], a[68:71], v[104:107], v[36:39]
    s_add_u32 m0, s40, 56320
    ds_read_b128 v[160:163], v13 offset:18944
    v_mfma_f32_16x16x32_bf16 v[44:47], a[60:63], v[100:103], v[44:47]
    v_mfma_f32_16x16x32_bf16 v[44:47], a[64:67], v[104:107], v[44:47]
    s_waitcnt vmcnt(11)
    v_mfma_f32_16x16x32_bf16 v[44:47], a[68:71], v[108:111], v[44:47]
    s_barrier
    ds_read_b64_tr_b16 a[72:73], v9 offset:0
    v_mfma_f32_16x16x32_bf16 v[52:55], a[60:63], v[104:107], v[52:55]
    buffer_load_dwordx4 v3, s[12:15], s51 offen lds
    v_mfma_f32_16x16x32_bf16 v[52:55], a[64:67], v[108:111], v[52:55]
    s_add_u32 m0, s40, 60416
    ds_read_b64_tr_b16 a[74:75], v9 offset:512
    v_mfma_f32_16x16x32_bf16 v[52:55], a[68:71], v[112:115], v[52:55]
    ds_read_b64_tr_b16 a[76:77], v9 offset:1024
    v_mfma_f32_16x16x32_bf16 v[60:63], a[60:63], v[108:111], v[60:63]
    buffer_load_dwordx4 v4, s[12:15], s51 offen lds
    v_mfma_f32_16x16x32_bf16 v[60:63], a[64:67], v[112:115], v[60:63]
    s_add_u32 m0, s39, 106496
    ds_read_b64_tr_b16 a[78:79], v9 offset:1536
    v_mfma_f32_16x16x32_bf16 v[60:63], a[68:71], v[116:119], v[60:63]
    ds_read_b64_tr_b16 a[80:81], v9 offset:2048
    v_mfma_f32_16x16x32_bf16 v[68:71], a[60:63], v[112:115], v[68:71]
    ds_read_b64_tr_b16 a[82:83], v9 offset:2560
    v_mfma_f32_16x16x32_bf16 v[68:71], a[64:67], v[116:119], v[68:71]
    buffer_load_dwordx4 v7, s[20:23], s57 offen lds
    v_mfma_f32_16x16x32_bf16 v[68:71], a[68:71], v[120:123], v[68:71]
    s_waitcnt lgkmcnt(4)
    v_mfma_f32_16x16x32_bf16 v[32:35], a[72:75], v[136:139], v[32:35]
    s_waitcnt lgkmcnt(2)
    v_mfma_f32_16x16x32_bf16 v[32:35], a[76:79], v[140:143], v[32:35]
    s_waitcnt lgkmcnt(0)
    v_mfma_f32_16x16x32_bf16 v[32:35], a[80:83], v[144:147], v[32:35]
    buffer_load_dwordx4 v7, s[24:27], s57 offen offset:1024 lds
    v_mfma_f32_16x16x32_bf16 v[40:43], a[72:75], v[140:143], v[40:43]
    v_mfma_f32_16x16x32_bf16 v[40:43], a[76:79], v[144:147], v[40:43]
    s_waitcnt vmcnt(8)
    v_mfma_f32_16x16x32_bf16 v[40:43], a[80:83], v[148:151], v[40:43]
    s_barrier
    ds_read_b64_tr_b16 a[84:85], v9 offset:12288
    v_mfma_f32_16x16x32_bf16 v[48:51], a[72:75], v[144:147], v[48:51]
    buffer_load_dwordx4 v7, s[28:31], s57 offen offset:2048 lds
    v_mfma_f32_16x16x32_bf16 v[48:51], a[76:79], v[148:151], v[48:51]
    s_add_u32 m0, s39, 118784
    ds_read_b64_tr_b16 a[86:87], v9 offset:12800
    v_mfma_f32_16x16x32_bf16 v[48:51], a[80:83], v[152:155], v[48:51]
    ds_read_b64_tr_b16 a[88:89], v9 offset:13312
    v_mfma_f32_16x16x32_bf16 v[56:59], a[72:75], v[148:151], v[56:59]
    ds_read_b64_tr_b16 a[90:91], v9 offset:13824
    v_mfma_f32_16x16x32_bf16 v[56:59], a[76:79], v[152:155], v[56:59]
    buffer_load_dwordx4 v7, s[20:23], s58 offen lds
    v_mfma_f32_16x16x32_bf16 v[56:59], a[80:83], v[156:159], v[56:59]
    ds_read_b64_tr_b16 a[92:93], v9 offset:14336
    v_mfma_f32_16x16x32_bf16 v[64:67], a[72:75], v[152:155], v[64:67]
    ds_read_b64_tr_b16 a[94:95], v9 offset:14848
    v_mfma_f32_16x16x32_bf16 v[64:67], a[76:79], v[156:159], v[64:67]
    ds_read_b128 a[192:195], v13 offset:34816
    v_mfma_f32_16x16x32_bf16 v[64:67], a[80:83], v[160:163], v[64:67]
    s_waitcnt lgkmcnt(5)
    buffer_load_dwordx4 v7, s[24:27], s58 offen offset:1024 lds
    v_mfma_f32_16x16x32_bf16 v[36:39], a[84:87], v[136:139], v[36:39]
    s_waitcnt lgkmcnt(3)
    ds_read_b128 a[196:199], v14 offset:35072
    v_mfma_f32_16x16x32_bf16 v[36:39], a[88:91], v[140:143], v[36:39]
    s_waitcnt lgkmcnt(2)
    ds_read_b128 a[200:203], v15 offset:35328
    v_mfma_f32_16x16x32_bf16 v[36:39], a[92:95], v[144:147], v[36:39]
    ds_read_b128 a[204:207], v16 offset:35584
    v_mfma_f32_16x16x32_bf16 v[44:47], a[84:87], v[140:143], v[44:47]
    buffer_load_dwordx4 v7, s[28:31], s58 offen offset:2048 lds
    v_mfma_f32_16x16x32_bf16 v[44:47], a[88:91], v[144:147], v[44:47]
    s_waitcnt vmcnt(9)
    ds_read_b128 a[208:211], v13 offset:35840
    v_mfma_f32_16x16x32_bf16 v[44:47], a[92:95], v[148:151], v[44:47]
    s_barrier
    ds_read_b64_tr_b16 a[96:97], v9 offset:24576
    v_mfma_f32_16x16x32_bf16 v[52:55], a[84:87], v[144:147], v[52:55]
    s_add_u32 m0, s39, 131072
    ds_read_b64_tr_b16 a[98:99], v9 offset:25088
    v_mfma_f32_16x16x32_bf16 v[52:55], a[88:91], v[148:151], v[52:55]
    buffer_load_dwordx4 v7, s[20:23], s59 offen lds
    v_mfma_f32_16x16x32_bf16 v[52:55], a[92:95], v[152:155], v[52:55]
    ds_read_b64_tr_b16 a[100:101], v9 offset:25600
    v_mfma_f32_16x16x32_bf16 v[60:63], a[84:87], v[148:151], v[60:63]
    ds_read_b64_tr_b16 a[102:103], v9 offset:26112
    v_mfma_f32_16x16x32_bf16 v[60:63], a[88:91], v[152:155], v[60:63]
    ds_read_b64_tr_b16 a[104:105], v9 offset:26624
    v_mfma_f32_16x16x32_bf16 v[60:63], a[92:95], v[156:159], v[60:63]
    buffer_load_dwordx4 v7, s[24:27], s59 offen offset:1024 lds
    v_mfma_f32_16x16x32_bf16 v[68:71], a[84:87], v[152:155], v[68:71]
    ds_read_b64_tr_b16 a[106:107], v9 offset:27136
    v_mfma_f32_16x16x32_bf16 v[68:71], a[88:91], v[156:159], v[68:71]
    ds_read_b128 a[212:215], v14 offset:36096
    v_mfma_f32_16x16x32_bf16 v[68:71], a[92:95], v[160:163], v[68:71]
    s_waitcnt lgkmcnt(5)
    ds_read_b128 a[216:219], v15 offset:36352
    v_mfma_f32_16x16x32_bf16 v[32:35], a[96:99], a[192:195], v[32:35]
    s_waitcnt lgkmcnt(4)
    buffer_load_dwordx4 v7, s[28:31], s59 offen offset:2048 lds
    v_mfma_f32_16x16x32_bf16 v[32:35], a[100:103], a[196:199], v[32:35]
    s_waitcnt lgkmcnt(2)
    ds_read_b128 v[136:139], v15 offset:34816
    v_mfma_f32_16x16x32_bf16 v[32:35], a[104:107], a[200:203], v[32:35]
    s_add_u32 m0, s39, 69632
    ds_read_b128 v[140:143], v16 offset:35072
    v_mfma_f32_16x16x32_bf16 v[40:43], a[96:99], a[196:199], v[40:43]
    ds_read_b128 v[144:147], v13 offset:35328
    v_mfma_f32_16x16x32_bf16 v[40:43], a[100:103], a[200:203], v[40:43]
    s_waitcnt vmcnt(6)
    buffer_load_dwordx4 v8, s[20:23], s56 offen lds
    v_mfma_f32_16x16x32_bf16 v[40:43], a[104:107], a[204:207], v[40:43]
    s_barrier
    ds_read_b64_tr_b16 a[120:121], v9 offset:36864
    v_mfma_f32_16x16x32_bf16 v[48:51], a[96:99], a[200:203], v[48:51]
    ds_read_b64_tr_b16 a[122:123], v9 offset:37376
    v_mfma_f32_16x16x32_bf16 v[48:51], a[100:103], a[204:207], v[48:51]
    ds_read_b64_tr_b16 a[124:125], v9 offset:37888
    v_mfma_f32_16x16x32_bf16 v[48:51], a[104:107], a[208:211], v[48:51]
    buffer_load_dwordx4 v8, s[24:27], s56 offen offset:1024 lds
    v_mfma_f32_16x16x32_bf16 v[56:59], a[96:99], a[204:207], v[56:59]
    ds_read_b64_tr_b16 a[126:127], v9 offset:38400
    v_mfma_f32_16x16x32_bf16 v[56:59], a[100:103], a[208:211], v[56:59]
    s_waitcnt lgkmcnt(4)
    ds_read_b64_tr_b16 a[128:129], v9 offset:38912
    v_mfma_f32_16x16x32_bf16 v[56:59], a[104:107], a[212:215], v[56:59]
    ds_read_b64_tr_b16 a[130:131], v9 offset:39424
    v_mfma_f32_16x16x32_bf16 v[64:67], a[96:99], a[208:211], v[64:67]
    buffer_load_dwordx4 v8, s[28:31], s56 offen offset:2048 lds
    v_mfma_f32_16x16x32_bf16 v[64:67], a[100:103], a[212:215], v[64:67]
    s_add_u32 m0, s39, 81920
    ds_read_b128 v[148:151], v14 offset:35584
    v_mfma_f32_16x16x32_bf16 v[64:67], a[104:107], a[216:219], v[64:67]
    s_waitcnt lgkmcnt(5)
    ds_read_b128 v[152:155], v15 offset:35840
    v_mfma_f32_16x16x32_bf16 v[32:35], a[120:123], v[136:139], v[32:35]
    s_waitcnt lgkmcnt(4)
    ds_read_b128 v[156:159], v16 offset:36096
    v_mfma_f32_16x16x32_bf16 v[32:35], a[124:127], v[140:143], v[32:35]
    s_waitcnt lgkmcnt(3)
    buffer_load_dwordx4 v8, s[20:23], s57 offen lds
    v_mfma_f32_16x16x32_bf16 v[32:35], a[128:131], v[144:147], v[32:35]
    ds_read_b128 v[160:163], v13 offset:36352
    v_mfma_f32_16x16x32_bf16 v[40:43], a[120:123], v[140:143], v[40:43]
    ds_read_b128 v[96:99], v13 offset:52224
    v_mfma_f32_16x16x32_bf16 v[40:43], a[124:127], v[144:147], v[40:43]
    s_waitcnt lgkmcnt(4) vmcnt(7)
    ds_read_b128 v[100:103], v14 offset:52480
    v_mfma_f32_16x16x32_bf16 v[40:43], a[128:131], v[148:151], v[40:43]
    s_barrier
    ds_read_b64_tr_b16 a[144:145], v9 offset:49152
    v_mfma_f32_16x16x32_bf16 v[48:51], a[120:123], v[144:147], v[48:51]
    buffer_load_dwordx4 v8, s[24:27], s57 offen offset:1024 lds
    v_mfma_f32_16x16x32_bf16 v[48:51], a[124:127], v[148:151], v[48:51]
    s_waitcnt lgkmcnt(4)
    ds_read_b64_tr_b16 a[146:147], v9 offset:49664
    v_mfma_f32_16x16x32_bf16 v[48:51], a[128:131], v[152:155], v[48:51]
    ds_read_b64_tr_b16 a[148:149], v9 offset:50176
    v_mfma_f32_16x16x32_bf16 v[56:59], a[120:123], v[148:151], v[56:59]
    buffer_load_dwordx4 v8, s[28:31], s57 offen offset:2048 lds
    v_mfma_f32_16x16x32_bf16 v[56:59], a[124:127], v[152:155], v[56:59]
    s_add_u32 m0, s39, 94208
    ds_read_b64_tr_b16 a[150:151], v9 offset:50688
    v_mfma_f32_16x16x32_bf16 v[56:59], a[128:131], v[156:159], v[56:59]
    ds_read_b64_tr_b16 a[152:153], v9 offset:51200
    v_mfma_f32_16x16x32_bf16 v[64:67], a[120:123], v[152:155], v[64:67]
    ds_read_b64_tr_b16 a[154:155], v9 offset:51712
    ds_read_b128 v[104:107], v15 offset:52736
    v_mfma_f32_16x16x32_bf16 v[64:67], a[124:127], v[156:159], v[64:67]
    s_waitcnt lgkmcnt(7)
    buffer_load_dwordx4 v8, s[20:23], s58 offen lds
    v_mfma_f32_16x16x32_bf16 v[64:67], a[128:131], v[160:163], v[64:67]
    s_waitcnt lgkmcnt(5)
    ds_read_b128 v[108:111], v16 offset:52992
    v_mfma_f32_16x16x32_bf16 v[32:35], a[144:147], v[96:99], v[32:35]
    s_waitcnt lgkmcnt(4)
    ds_read_b128 v[112:115], v13 offset:53248
    v_mfma_f32_16x16x32_bf16 v[32:35], a[148:151], v[100:103], v[32:35]
    s_waitcnt lgkmcnt(2)
    ds_read_b128 v[116:119], v14 offset:53504
    v_mfma_f32_16x16x32_bf16 v[32:35], a[152:155], v[104:107], v[32:35]
    buffer_load_dwordx4 v8, s[24:27], s58 offen offset:1024 lds
    v_mfma_f32_16x16x32_bf16 v[40:43], a[144:147], v[100:103], v[40:43]
    ds_read_b128 v[120:123], v15 offset:53760
    v_mfma_f32_16x16x32_bf16 v[40:43], a[148:151], v[104:107], v[40:43]
    s_waitcnt lgkmcnt(3) vmcnt(8)
    ds_read_b128 v[176:179], v15 offset:52224
    v_mfma_f32_16x16x32_bf16 v[40:43], a[152:155], v[108:111], v[40:43]
    s_barrier
    ds_read_b64_tr_b16 a[168:169], v10 offset:0
    v_mfma_f32_16x16x32_bf16 v[48:51], a[144:147], v[104:107], v[48:51]
    buffer_load_dwordx4 v8, s[28:31], s58 offen offset:2048 lds
    v_mfma_f32_16x16x32_bf16 v[48:51], a[148:151], v[108:111], v[48:51]
    s_waitcnt lgkmcnt(4)
    ds_read_b64_tr_b16 a[170:171], v10 offset:512
    v_mfma_f32_16x16x32_bf16 v[48:51], a[152:155], v[112:115], v[48:51]
    s_add_u32 m0, s39, 106496
    ds_read_b64_tr_b16 a[172:173], v10 offset:1024
    v_mfma_f32_16x16x32_bf16 v[56:59], a[144:147], v[108:111], v[56:59]
    ds_read_b64_tr_b16 a[174:175], v10 offset:1536
    v_mfma_f32_16x16x32_bf16 v[56:59], a[148:151], v[112:115], v[56:59]
    s_waitcnt lgkmcnt(5)
    buffer_load_dwordx4 v8, s[20:23], s59 offen lds
    v_mfma_f32_16x16x32_bf16 v[56:59], a[152:155], v[116:119], v[56:59]
    ds_read_b128 v[180:183], v16 offset:52480
    v_mfma_f32_16x16x32_bf16 v[64:67], a[144:147], v[112:115], v[64:67]
    ds_read_b64_tr_b16 a[176:177], v10 offset:2048
    ds_read_b64_tr_b16 a[178:179], v10 offset:2560
    v_mfma_f32_16x16x32_bf16 v[64:67], a[148:151], v[116:119], v[64:67]
    ds_read_b128 v[184:187], v13 offset:52736
    v_mfma_f32_16x16x32_bf16 v[64:67], a[152:155], v[120:123], v[64:67]
    s_waitcnt lgkmcnt(6)
    buffer_load_dwordx4 v8, s[24:27], s59 offen offset:1024 lds
    v_mfma_f32_16x16x32_bf16 v[32:35], a[168:171], v[176:179], v[32:35]
    s_waitcnt lgkmcnt(3)
    ds_read_b128 v[188:191], v14 offset:52992
    v_mfma_f32_16x16x32_bf16 v[32:35], a[172:175], v[180:183], v[32:35]
    s_waitcnt lgkmcnt(1)
    ds_read_b128 v[192:195], v15 offset:53248
    v_mfma_f32_16x16x32_bf16 v[32:35], a[176:179], v[184:187], v[32:35]
L_pick:
    s_cbranch_scc1 L_w0
    ds_read_b128 v[196:199], v16 offset:53504
    v_mfma_f32_16x16x32_bf16 v[40:43], a[168:171], v[180:183], v[40:43]
    buffer_load_dwordx4 v8, s[28:31], s59 offen offset:2048 lds
    v_mfma_f32_16x16x32_bf16 v[40:43], a[172:175], v[184:187], v[40:43]
    s_waitcnt lgkmcnt(2) vmcnt(9)
    ds_read_b128 v[200:203], v13 offset:53760
    v_mfma_f32_16x16x32_bf16 v[40:43], a[176:179], v[188:191], v[40:43]
    s_barrier
    ds_read_b64_tr_b16 a[108:109], v9 offset:0
    v_mfma_f32_16x16x32_bf16 v[48:51], a[168:171], v[184:187], v[48:51]
    s_add_u32 m0, s40, 12288
    ds_read_b64_tr_b16 a[110:111], v9 offset:512
    v_mul_f32 v32, s44, v32
    v_mfma_f32_16x16x32_bf16 v[48:51], a[172:175], v[188:191], v[48:51]
    s_waitcnt lgkmcnt(4)
    buffer_load_dwordx4 v5, s[12:15], s48 offen lds
    v_mul_f32 v33, s44, v33
    v_mfma_f32_16x16x32_bf16 v[48:51], a[176:179], v[192:195], v[48:51]
    s_add_u32 m0, s40, 29696
    ds_read_b64_tr_b16 a[112:113], v9 offset:1024
    v_mul_f32 v34, s44, v34
    v_mfma_f32_16x16x32_bf16 v[56:59], a[168:171], v[188:191], v[56:59]
    ds_read_b64_tr_b16 a[114:115], v9 offset:1536
    v_mul_f32 v35, s44, v35
    v_mfma_f32_16x16x32_bf16 v[56:59], a[172:175], v[192:195], v[56:59]
    s_waitcnt lgkmcnt(5)
    ds_read_b64_tr_b16 a[116:117], v9 offset:2048
    v_min_f32 v32, s43, v32
    v_mfma_f32_16x16x32_bf16 v[56:59], a[176:179], v[196:199], v[56:59]
    buffer_load_dwordx4 v5, s[12:15], s49 offen lds
    v_min_f32 v33, s43, v33
    v_mfma_f32_16x16x32_bf16 v[64:67], a[168:171], v[192:195], v[64:67]
    s_add_u32 m0, s40, 47104
    ds_read_b64_tr_b16 a[118:119], v9 offset:2560
    v_min_f32 v34, s43, v34
    v_mfma_f32_16x16x32_bf16 v[64:67], a[172:175], v[196:199], v[64:67]
    s_waitcnt lgkmcnt(6)
    v_min_f32 v35, s43, v35
    v_mul_f32 v40, s44, v40
    v_mfma_f32_16x16x32_bf16 v[64:67], a[176:179], v[200:203], v[64:67]
    s_waitcnt lgkmcnt(4)
    v_exp_f32 v32, v32
    v_mfma_f32_16x16x32_bf16 v[36:39], a[108:111], a[192:195], v[36:39]
    s_waitcnt lgkmcnt(2)
    buffer_load_dwordx4 v5, s[12:15], s50 offen lds
    v_mul_f32 v41, s44, v41
    v_mfma_f32_16x16x32_bf16 v[36:39], a[112:115], a[196:199], v[36:39]
    s_waitcnt lgkmcnt(0)
    v_exp_f32 v33, v33
    v_mfma_f32_16x16x32_bf16 v[36:39], a[116:119], a[200:203], v[36:39]
    s_add_u32 m0, s40, 64512
    v_exp_f32 v34, v34
    v_mfma_f32_16x16x32_bf16 v[44:47], a[108:111], a[196:199], v[44:47]
    v_exp_f32 v35, v35
    v_mfma_f32_16x16x32_bf16 v[44:47], a[112:115], a[200:203], v[44:47]
    s_waitcnt vmcnt(9)
    buffer_load_dwordx4 v5, s[12:15], s51 offen lds
    v_add_f32 v224, 1.0, v32
    v_mfma_f32_16x16x32_bf16 v[44:47], a[116:119], a[204:207], v[44:47]
    s_barrier
    ds_read_b64_tr_b16 a[132:133], v9 offset:12288
    v_mfma_f32_16x16x32_bf16 v[52:55], a[108:111], a[200:203], v[52:55]
    ds_read_b64_tr_b16 a[134:135], v9 offset:12800
    v_add_f32 v225, 1.0, v33
    v_mfma_f32_16x16x32_bf16 v[52:55], a[112:115], a[204:207], v[52:55]
    ds_read_b64_tr_b16 a[136:137], v9 offset:13312
    v_add_f32 v226, 1.0, v34
    v_mfma_f32_16x16x32_bf16 v[52:55], a[116:119], a[208:211], v[52:55]
    ds_read_b64_tr_b16 a[138:139], v9 offset:13824
    v_add_f32 v227, 1.0, v35
    v_mfma_f32_16x16x32_bf16 v[60:63], a[108:111], a[204:207], v[60:63]
    ds_read_b64_tr_b16 a[140:141], v9 offset:14336
    v_mul_f32 v42, s44, v42
    v_mfma_f32_16x16x32_bf16 v[60:63], a[112:115], a[208:211], v[60:63]
    ds_read_b64_tr_b16 a[142:143], v9 offset:14848
    v_mul_f32 v43, s44, v43
    v_mfma_f32_16x16x32_bf16 v[60:63], a[116:119], a[212:215], v[60:63]
    v_min_f32 v40, s43, v40
    v_min_f32 v41, s43, v41
    v_mfma_f32_16x16x32_bf16 v[68:71], a[108:111], a[208:211], v[68:71]
    v_min_f32 v42, s43, v42
    v_min_f32 v43, s43, v43
    v_mfma_f32_16x16x32_bf16 v[68:71], a[112:115], a[212:215], v[68:71]
    v_exp_f32 v40, v40
    v_mfma_f32_16x16x32_bf16 v[68:71], a[116:119], a[216:219], v[68:71]
    s_waitcnt lgkmcnt(4)
    v_exp_f32 v41, v41
    v_mfma_f32_16x16x32_bf16 v[36:39], a[132:135], v[136:139], v[36:39]
    s_waitcnt lgkmcnt(2)
    v_exp_f32 v42, v42
    v_mfma_f32_16x16x32_bf16 v[36:39], a[136:139], v[140:143], v[36:39]
    s_waitcnt lgkmcnt(0)
    v_exp_f32 v43, v43
    v_mfma_f32_16x16x32_bf16 v[36:39], a[140:143], v[144:147], v[36:39]
    v_add_f32 v228, 1.0, v40
    v_add_f32 v229, 1.0, v41
    v_mfma_f32_16x16x32_bf16 v[44:47], a[132:135], v[140:143], v[44:47]
    v_add_f32 v230, 1.0, v42
    v_add_f32 v231, 1.0, v43
    v_mfma_f32_16x16x32_bf16 v[44:47], a[136:139], v[144:147], v[44:47]
    s_waitcnt vmcnt(7)
    v_mul_f32 v48, s44, v48
    v_mul_f32 v49, s44, v49
    v_mfma_f32_16x16x32_bf16 v[44:47], a[140:143], v[148:151], v[44:47]
    s_barrier
    ds_read_b64_tr_b16 a[156:157], v9 offset:24576
    v_mfma_f32_16x16x32_bf16 v[52:55], a[132:135], v[144:147], v[52:55]
    ds_read_b64_tr_b16 a[158:159], v9 offset:25088
    v_mul_f32 v50, s44, v50
    v_mfma_f32_16x16x32_bf16 v[52:55], a[136:139], v[148:151], v[52:55]
    ds_read_b64_tr_b16 a[160:161], v9 offset:25600
    v_mul_f32 v51, s44, v51
    v_mfma_f32_16x16x32_bf16 v[52:55], a[140:143], v[152:155], v[52:55]
    ds_read_b64_tr_b16 a[162:163], v9 offset:26112
    v_min_f32 v48, s43, v48
    v_mfma_f32_16x16x32_bf16 v[60:63], a[132:135], v[148:151], v[60:63]
    ds_read_b64_tr_b16 a[164:165], v9 offset:26624
    v_min_f32 v49, s43, v49
    v_mfma_f32_16x16x32_bf16 v[60:63], a[136:139], v[152:155], v[60:63]
    ds_read_b64_tr_b16 a[166:167], v9 offset:27136
    v_min_f32 v50, s43, v50
    v_mfma_f32_16x16x32_bf16 v[60:63], a[140:143], v[156:159], v[60:63]
    v_min_f32 v51, s43, v51
    v_mul_f32 v56, s44, v56
    v_mfma_f32_16x16x32_bf16 v[68:71], a[132:135], v[152:155], v[68:71]
    v_exp_f32 v48, v48
    v_mfma_f32_16x16x32_bf16 v[68:71], a[136:139], v[156:159], v[68:71]
    v_exp_f32 v49, v49
    v_mfma_f32_16x16x32_bf16 v[68:71], a[140:143], v[160:163], v[68:71]
    s_waitcnt lgkmcnt(4)
    v_exp_f32 v50, v50
    v_mfma_f32_16x16x32_bf16 v[36:39], a[156:159], v[96:99], v[36:39]
    s_waitcnt lgkmcnt(2)
    v_exp_f32 v51, v51
    v_mfma_f32_16x16x32_bf16 v[36:39], a[160:163], v[100:103], v[36:39]
    s_waitcnt lgkmcnt(0)
    v_add_f32 v232, 1.0, v48
    v_add_f32 v233, 1.0, v49
    v_mfma_f32_16x16x32_bf16 v[36:39], a[164:167], v[104:107], v[36:39]
    v_add_f32 v234, 1.0, v50
    v_add_f32 v235, 1.0, v51
    v_mfma_f32_16x16x32_bf16 v[44:47], a[156:159], v[100:103], v[44:47]
    v_mul_f32 v57, s44, v57
    v_mul_f32 v58, s44, v58
    v_mfma_f32_16x16x32_bf16 v[44:47], a[160:163], v[104:107], v[44:47]
    s_waitcnt vmcnt(4)
    v_mul_f32 v59, s44, v59
    v_min_f32 v56, s43, v56
    v_mfma_f32_16x16x32_bf16 v[44:47], a[164:167], v[108:111], v[44:47]
    s_barrier
    ds_read_b64_tr_b16 a[180:181], v9 offset:36864
    v_mfma_f32_16x16x32_bf16 v[52:55], a[156:159], v[104:107], v[52:55]
    ds_read_b64_tr_b16 a[182:183], v9 offset:37376
    v_min_f32 v57, s43, v57
    v_mfma_f32_16x16x32_bf16 v[52:55], a[160:163], v[108:111], v[52:55]
    ds_read_b64_tr_b16 a[184:185], v9 offset:37888
    v_min_f32 v58, s43, v58
    v_mfma_f32_16x16x32_bf16 v[52:55], a[164:167], v[112:115], v[52:55]
    ds_read_b64_tr_b16 a[186:187], v9 offset:38400
    v_min_f32 v59, s43, v59
    v_mfma_f32_16x16x32_bf16 v[60:63], a[156:159], v[108:111], v[60:63]
    ds_read_b64_tr_b16 a[188:189], v9 offset:38912
    v_mul_f32 v64, s44, v64
    v_mfma_f32_16x16x32_bf16 v[60:63], a[160:163], v[112:115], v[60:63]
    ds_read_b64_tr_b16 a[190:191], v9 offset:39424
    v_mul_f32 v65, s44, v65
    v_mfma_f32_16x16x32_bf16 v[60:63], a[164:167], v[116:119], v[60:63]
    v_exp_f32 v56, v56
    v_mfma_f32_16x16x32_bf16 v[68:71], a[156:159], v[112:115], v[68:71]
    v_exp_f32 v57, v57
    v_mfma_f32_16x16x32_bf16 v[68:71], a[160:163], v[116:119], v[68:71]
    v_exp_f32 v58, v58
    v_mfma_f32_16x16x32_bf16 v[68:71], a[164:167], v[120:123], v[68:71]
    s_waitcnt lgkmcnt(4)
    v_exp_f32 v59, v59
    v_mfma_f32_16x16x32_bf16 v[36:39], a[180:183], v[176:179], v[36:39]
    s_waitcnt lgkmcnt(2)
    v_add_f32 v236, 1.0, v56
    v_add_f32 v237, 1.0, v57
    v_mfma_f32_16x16x32_bf16 v[36:39], a[184:187], v[180:183], v[36:39]
    s_waitcnt lgkmcnt(0)
    v_add_f32 v238, 1.0, v58
    v_add_f32 v239, 1.0, v59
    v_mfma_f32_16x16x32_bf16 v[36:39], a[188:191], v[184:187], v[36:39]
    v_mul_f32 v66, s44, v66
    v_mul_f32 v67, s44, v67
    v_mfma_f32_16x16x32_bf16 v[44:47], a[180:183], v[180:183], v[44:47]
    v_min_f32 v64, s43, v64
    v_min_f32 v65, s43, v65
    v_mfma_f32_16x16x32_bf16 v[44:47], a[184:187], v[184:187], v[44:47]
    v_min_f32 v66, s43, v66
    v_min_f32 v67, s43, v67
    v_mfma_f32_16x16x32_bf16 v[44:47], a[188:191], v[188:191], v[44:47]
    v_exp_f32 v64, v64
    v_mfma_f32_16x16x32_bf16 v[52:55], a[180:183], v[184:187], v[52:55]
    v_exp_f32 v65, v65
    v_exp_f32 v66, v66
    v_exp_f32 v67, v67
    v_pk_add_f32 v[240:241], v[64:65], 1.0 op_sel_hi:[1,0]
    v_pk_add_f32 v[242:243], v[66:67], 1.0 op_sel_hi:[1,0]
    v_pk_mul_f32 v[36:37], v[36:37], s[46:47]
    v_pk_mul_f32 v[38:39], v[38:39], s[46:47]
    v_exp_f32 v36, v36
    v_exp_f32 v37, v37
    v_exp_f32 v38, v38
    v_exp_f32 v39, v39
    v_pk_fma_f32 v[224:225], v[224:225], v[36:37], v[224:225]
    v_pk_fma_f32 v[226:227], v[226:227], v[38:39], v[226:227]
    v_rcp_f32 v36, v224
    v_rcp_f32 v37, v225
    s_waitcnt vmcnt(0)
    v_mfma_f32_16x16x32_bf16 v[52:55], a[184:187], v[188:191], v[52:55]
    s_barrier
    ds_read_b128 a[192:195], v17 offset:0
    v_mfma_f32_16x16x32_bf16 v[52:55], a[188:191], v[192:195], v[52:55]
    ds_read_b128 a[196:199], v19 offset:0
    ds_read_b128 a[200:203], v17 offset:17408
    v_mfma_f32_16x16x32_bf16 v[60:63], a[180:183], v[188:191], v[60:63]
    ds_read_b128 a[204:207], v19 offset:17408
    v_mul_f32 v44, s46, v44
    v_mfma_f32_16x16x32_bf16 v[60:63], a[184:187], v[192:195], v[60:63]
    ds_read_b128 a[208:211], v17 offset:34816
    v_mul_f32 v45, s46, v45
    v_mfma_f32_16x16x32_bf16 v[60:63], a[188:191], v[196:199], v[60:63]
    ds_read_b128 a[212:215], v19 offset:34816
    v_mul_f32 v46, s46, v46
    v_mfma_f32_16x16x32_bf16 v[68:71], a[180:183], v[192:195], v[68:71]
    ds_read_b128 a[216:219], v17 offset:52224
    v_mul_f32 v47, s46, v47
    v_mfma_f32_16x16x32_bf16 v[68:71], a[184:187], v[196:199], v[68:71]
    v_rcp_f32 v38, v226
    v_mfma_f32_16x16x32_bf16 v[68:71], a[188:191], v[200:203], v[68:71]
    s_waitcnt lgkmcnt(6)
    ds_read_b128 a[220:223], v19 offset:52224
    ds_read_b128 a[224:227], v18 offset:256
    v_mfma_f32_16x16x32_bf16 v[72:75], a[0:3], a[192:195], 0
    s_waitcnt lgkmcnt(6)
    v_rcp_f32 v39, v227
    v_mfma_f32_16x16x32_bf16 v[72:75], a[24:27], a[196:199], v[72:75]
    ds_read_b128 a[228:231], v20 offset:256
    v_fma_f32 v32, v32, v36, -v36
    v_mfma_f32_16x16x32_bf16 v[72:75], a[48:51], a[200:203], v[72:75]
    s_waitcnt lgkmcnt(5)
    ds_read_b128 a[232:235], v18 offset:17664
    v_fma_f32 v33, v33, v37, -v37
    v_mfma_f32_16x16x32_bf16 v[72:75], a[72:75], a[204:207], v[72:75]
    ds_read_b128 a[236:239], v20 offset:17664
    v_fma_f32 v34, v34, v38, -v38
    v_mfma_f32_16x16x32_bf16 v[72:75], a[96:99], a[208:211], v[72:75]
    s_waitcnt lgkmcnt(5)
    ds_read_b128 a[240:243], v18 offset:35072
    v_fma_f32 v35, v35, v39, -v39
    v_mfma_f32_16x16x32_bf16 v[72:75], a[120:123], a[212:215], v[72:75]
    ds_read_b128 a[244:247], v20 offset:35072
    v_cvt_pk_bf16_f32 v36, v32, v33
    v_mfma_f32_16x16x32_bf16 v[72:75], a[144:147], a[216:219], v[72:75]
    s_waitcnt lgkmcnt(5)
    ds_read_b128 a[248:251], v18 offset:52480
    v_cvt_pk_bf16_f32 v37, v34, v35
    v_mfma_f32_16x16x32_bf16 v[72:75], a[168:171], a[220:223], v[72:75]
    v_exp_f32 v44, v44
    v_mfma_f32_16x16x32_bf16 v[76:79], a[12:15], a[192:195], 0
    v_exp_f32 v45, v45
    v_mfma_f32_16x16x32_bf16 v[76:79], a[36:39], a[196:199], v[76:79]
    v_exp_f32 v46, v46
    v_mfma_f32_16x16x32_bf16 v[76:79], a[60:63], a[200:203], v[76:79]
    v_exp_f32 v47, v47
    v_mfma_f32_16x16x32_bf16 v[76:79], a[84:87], a[204:207], v[76:79]
    ds_write_b64 v11, v[36:37] offset:0
    v_fmac_f32 v228, v228, v44
    v_mfma_f32_16x16x32_bf16 v[76:79], a[108:111], a[208:211], v[76:79]
    ds_read_b128 a[252:255], v20 offset:52480
    v_fmac_f32 v229, v229, v45
    v_mfma_f32_16x16x32_bf16 v[76:79], a[132:135], a[212:215], v[76:79]
    ds_read_b128 v[176:179], v19 offset:512
    v_fmac_f32 v230, v230, v46
    v_mfma_f32_16x16x32_bf16 v[76:79], a[156:159], a[216:219], v[76:79]
    ds_read_b128 v[180:183], v17 offset:512
    v_fmac_f32 v231, v231, v47
    v_mfma_f32_16x16x32_bf16 v[76:79], a[180:183], a[220:223], v[76:79]
    ds_read_b128 v[184:187], v19 offset:17920
    v_mul_f32 v52, s46, v52
    v_mfma_f32_16x16x32_bf16 v[72:75], a[4:7], a[224:227], v[72:75]
    s_waitcnt lgkmcnt(5)
    ds_read_b128 v[188:191], v17 offset:17920
    v_mul_f32 v53, s46, v53
    v_mfma_f32_16x16x32_bf16 v[72:75], a[28:31], a[228:231], v[72:75]
    ds_read_b128 v[192:195], v19 offset:35328
    v_mul_f32 v54, s46, v54
    v_mfma_f32_16x16x32_bf16 v[72:75], a[52:55], a[232:235], v[72:75]
    ds_read_b128 v[196:199], v17 offset:35328
    v_mul_f32 v55, s46, v55
    v_mfma_f32_16x16x32_bf16 v[72:75], a[76:79], a[236:239], v[72:75]
    v_rcp_f32 v44, v228
    v_mfma_f32_16x16x32_bf16 v[72:75], a[100:103], a[240:243], v[72:75]
    v_rcp_f32 v45, v229
    v_mfma_f32_16x16x32_bf16 v[72:75], a[124:127], a[244:247], v[72:75]
    v_rcp_f32 v46, v230
    v_mfma_f32_16x16x32_bf16 v[72:75], a[148:151], a[248:251], v[72:75]
    s_waitcnt lgkmcnt(3)
    v_rcp_f32 v47, v231
    v_mfma_f32_16x16x32_bf16 v[72:75], a[172:175], a[252:255], v[72:75]
    ds_read_b128 v[200:203], v19 offset:52736
    v_fma_f32 v40, v40, v44, -v44
    v_mfma_f32_16x16x32_bf16 v[76:79], a[16:19], a[224:227], v[76:79]
    ds_read_b128 v[204:207], v17 offset:52736
    v_fma_f32 v41, v41, v45, -v45
    v_mfma_f32_16x16x32_bf16 v[76:79], a[40:43], a[228:231], v[76:79]
    ds_read_b128 a[192:195], v20 offset:768
    v_fma_f32 v42, v42, v46, -v46
    v_mfma_f32_16x16x32_bf16 v[76:79], a[64:67], a[232:235], v[76:79]
    ds_read_b128 a[196:199], v18 offset:768
    v_fma_f32 v43, v43, v47, -v47
    v_mfma_f32_16x16x32_bf16 v[76:79], a[88:91], a[236:239], v[76:79]
    ds_read_b128 a[200:203], v20 offset:18176
    v_cvt_pk_bf16_f32 v44, v40, v41
    v_mfma_f32_16x16x32_bf16 v[76:79], a[112:115], a[240:243], v[76:79]
    ds_read_b128 a[204:207], v18 offset:18176
    v_cvt_pk_bf16_f32 v45, v42, v43
    v_mfma_f32_16x16x32_bf16 v[76:79], a[136:139], a[244:247], v[76:79]
    v_exp_f32 v52, v52
    v_mfma_f32_16x16x32_bf16 v[76:79], a[160:163], a[248:251], v[76:79]
    v_exp_f32 v53, v53
    v_mfma_f32_16x16x32_bf16 v[76:79], a[184:187], a[252:255], v[76:79]
    v_exp_f32 v54, v54
    v_mfma_f32_16x16x32_bf16 v[72:75], a[8:11], v[176:179], v[72:75]
    v_exp_f32 v55, v55
    v_mfma_f32_16x16x32_bf16 v[72:75], a[32:35], v[180:183], v[72:75]
    ds_write_b64 v11, v[44:45] offset:2048
    v_fmac_f32 v232, v232, v52
    v_mfma_f32_16x16x32_bf16 v[72:75], a[56:59], v[184:187], v[72:75]
    s_waitcnt lgkmcnt(2)
    ds_write_b32 v211, v217
    ds_read_b128 a[208:211], v20 offset:35584
    v_mfma_f32_16x16x32_bf16 v[72:75], a[80:83], v[188:191], v[72:75]
    ds_read_b128 a[212:215], v18 offset:35584
    v_fmac_f32 v233, v233, v53
    v_mfma_f32_16x16x32_bf16 v[72:75], a[104:107], v[192:195], v[72:75]
    ds_read_b128 a[216:219], v20 offset:52992
    v_fmac_f32 v234, v234, v54
    v_mfma_f32_16x16x32_bf16 v[72:75], a[128:131], v[196:199], v[72:75]
    ds_read_b128 a[220:223], v18 offset:52992
    v_fmac_f32 v235, v235, v55
    v_mfma_f32_16x16x32_bf16 v[72:75], a[152:155], v[200:203], v[72:75]
    v_rcp_f32 v52, v232
    v_mfma_f32_16x16x32_bf16 v[72:75], a[176:179], v[204:207], v[72:75]
    v_rcp_f32 v53, v233
    v_mfma_f32_16x16x32_bf16 v[76:79], a[20:23], v[176:179], v[76:79]
    v_rcp_f32 v54, v234
    v_mfma_f32_16x16x32_bf16 v[76:79], a[44:47], v[180:183], v[76:79]
    v_rcp_f32 v55, v235
    v_mfma_f32_16x16x32_bf16 v[76:79], a[68:71], v[184:187], v[76:79]
    ds_read_b32 v220, v212
    v_fma_f32 v48, v48, v52, -v52
    v_mfma_f32_16x16x32_bf16 v[76:79], a[92:95], v[188:191], v[76:79]
    ds_read_b128 v[32:35], v12 offset:0
    v_fma_f32 v49, v49, v53, -v53
    v_mfma_f32_16x16x32_bf16 v[76:79], a[116:119], v[192:195], v[76:79]
    v_fma_f32 v50, v50, v54, -v54
    v_fma_f32 v51, v51, v55, -v55
    v_mfma_f32_16x16x32_bf16 v[76:79], a[140:143], v[196:199], v[76:79]
    v_cvt_pk_bf16_f32 v52, v48, v49
    v_cvt_pk_bf16_f32 v53, v50, v51
    v_mfma_f32_16x16x32_bf16 v[76:79], a[164:167], v[200:203], v[76:79]
    ds_write_b64 v11, v[52:53] offset:4096
    v_mul_f32 v60, s46, v60
    v_mfma_f32_16x16x32_bf16 v[76:79], a[188:191], v[204:207], v[76:79]
    v_mul_f32 v61, s46, v61
    v_mul_f32 v62, s46, v62
    v_mfma_f32_16x16x32_bf16 v[80:83], a[0:3], a[224:227], 0
    v_mul_f32 v63, s46, v63
    v_mul_f32 v68, s46, v68
    v_mfma_f32_16x16x32_bf16 v[80:83], a[24:27], a[228:231], v[80:83]
    s_waitcnt lgkmcnt(1)
    buffer_store_dwordx4 v[32:35], v208, s[16:19], 0 offen offset:0 sc1
    v_mul_f32 v69, s46, v69
    v_mfma_f32_16x16x32_bf16 v[80:83], a[48:51], a[232:235], v[80:83]
    v_exp_f32 v60, v60
    v_mfma_f32_16x16x32_bf16 v[80:83], a[72:75], a[236:239], v[80:83]
    v_exp_f32 v61, v61
    v_mfma_f32_16x16x32_bf16 v[80:83], a[96:99], a[240:243], v[80:83]
    v_exp_f32 v62, v62
    v_mfma_f32_16x16x32_bf16 v[80:83], a[120:123], a[244:247], v[80:83]
    v_exp_f32 v63, v63
    v_mfma_f32_16x16x32_bf16 v[80:83], a[144:147], a[248:251], v[80:83]
    v_fmac_f32 v236, v236, v60
    v_fmac_f32 v237, v237, v61
    v_mfma_f32_16x16x32_bf16 v[80:83], a[168:171], a[252:255], v[80:83]
    v_fmac_f32 v238, v238, v62
    v_fmac_f32 v239, v239, v63
    v_mfma_f32_16x16x32_bf16 v[84:87], a[12:15], a[224:227], 0
    ds_read_b128 a[224:227], v17 offset:1024
    v_mul_f32 v70, s46, v70
    v_mfma_f32_16x16x32_bf16 v[84:87], a[36:39], a[228:231], v[84:87]
    ds_read_b128 a[228:231], v19 offset:1024
    v_mul_f32 v71, s46, v71
    v_mfma_f32_16x16x32_bf16 v[84:87], a[60:63], a[232:235], v[84:87]
    v_rcp_f32 v60, v236
    v_mfma_f32_16x16x32_bf16 v[84:87], a[84:87], a[236:239], v[84:87]
    v_rcp_f32 v61, v237
    v_mfma_f32_16x16x32_bf16 v[84:87], a[108:111], a[240:243], v[84:87]
    v_rcp_f32 v62, v238
    v_mfma_f32_16x16x32_bf16 v[84:87], a[132:135], a[244:247], v[84:87]
    v_rcp_f32 v63, v239
    v_mfma_f32_16x16x32_bf16 v[84:87], a[156:159], a[248:251], v[84:87]
    ds_read_b128 a[232:235], v17 offset:18432
    v_fma_f32 v56, v56, v60, -v60
    v_mfma_f32_16x16x32_bf16 v[84:87], a[180:183], a[252:255], v[84:87]
    ds_read_b128 a[236:239], v19 offset:18432
    v_fma_f32 v57, v57, v61, -v61
    v_mfma_f32_16x16x32_bf16 v[80:83], a[4:7], v[176:179], v[80:83]
    ds_read_b128 a[240:243], v17 offset:35840
    v_fma_f32 v58, v58, v62, -v62
    v_mfma_f32_16x16x32_bf16 v[80:83], a[28:31], v[180:183], v[80:83]
    ds_read_b128 a[244:247], v19 offset:35840
    v_fma_f32 v59, v59, v63, -v63
    v_mfma_f32_16x16x32_bf16 v[80:83], a[52:55], v[184:187], v[80:83]
    ds_read_b128 a[248:251], v17 offset:53248
    v_cvt_pk_bf16_f32 v60, v56, v57
    v_mfma_f32_16x16x32_bf16 v[80:83], a[76:79], v[188:191], v[80:83]
    ds_read_b128 a[252:255], v19 offset:53248
    v_cvt_pk_bf16_f32 v61, v58, v59
    v_mfma_f32_16x16x32_bf16 v[80:83], a[100:103], v[192:195], v[80:83]
    v_exp_f32 v68, v68
    v_mfma_f32_16x16x32_bf16 v[80:83], a[124:127], v[196:199], v[80:83]
    v_exp_f32 v69, v69
    v_mfma_f32_16x16x32_bf16 v[80:83], a[148:151], v[200:203], v[80:83]
    v_exp_f32 v70, v70
    v_mfma_f32_16x16x32_bf16 v[80:83], a[172:175], v[204:207], v[80:83]
    v_exp_f32 v71, v71
    v_mfma_f32_16x16x32_bf16 v[84:87], a[16:19], v[176:179], v[84:87]
    ds_write_b64 v11, v[60:61] offset:6144
    v_fmac_f32 v240, v240, v68
    v_mfma_f32_16x16x32_bf16 v[84:87], a[40:43], v[180:183], v[84:87]
    ds_write_b32 v211, v218
    v_fmac_f32 v241, v241, v69
    v_mfma_f32_16x16x32_bf16 v[84:87], a[64:67], v[184:187], v[84:87]
    v_fmac_f32 v242, v242, v70
    v_fmac_f32 v243, v243, v71
    v_mfma_f32_16x16x32_bf16 v[84:87], a[88:91], v[188:191], v[84:87]
    v_rcp_f32 v68, v240
    v_mfma_f32_16x16x32_bf16 v[84:87], a[112:115], v[192:195], v[84:87]
    v_rcp_f32 v69, v241
    v_mfma_f32_16x16x32_bf16 v[84:87], a[136:139], v[196:199], v[84:87]
    v_rcp_f32 v70, v242
    v_mfma_f32_16x16x32_bf16 v[84:87], a[160:163], v[200:203], v[84:87]
    v_rcp_f32 v71, v243
    v_mfma_f32_16x16x32_bf16 v[84:87], a[184:187], v[204:207], v[84:87]
    v_fma_f32 v64, v64, v68, -v68
    v_fma_f32 v65, v65, v69, -v69
    v_mfma_f32_16x16x32_bf16 v[80:83], a[8:11], a[192:195], v[80:83]
    v_fma_f32 v66, v66, v70, -v70
    v_fma_f32 v67, v67, v71, -v71
    v_mfma_f32_16x16x32_bf16 v[80:83], a[32:35], a[196:199], v[80:83]
    ds_read_b32 v221, v212
    v_cvt_pk_bf16_f32 v68, v64, v65
    v_mfma_f32_16x16x32_bf16 v[80:83], a[56:59], a[200:203], v[80:83]
    ds_read_b128 v[48:51], v12 offset:4096
    v_cvt_pk_bf16_f32 v69, v66, v67
    v_mfma_f32_16x16x32_bf16 v[80:83], a[80:83], a[204:207], v[80:83]
    ds_write_b64 v11, v[68:69] offset:8192
    v_mul_f32 v72, s44, v72
    v_mfma_f32_16x16x32_bf16 v[80:83], a[104:107], a[208:211], v[80:83]
    v_mul_f32 v73, s44, v73
    v_mul_f32 v74, s44, v74
    v_mfma_f32_16x16x32_bf16 v[80:83], a[128:131], a[212:215], v[80:83]
    v_mul_f32 v75, s44, v75
    v_min_f32 v72, s43, v72
    v_mfma_f32_16x16x32_bf16 v[80:83], a[152:155], a[216:219], v[80:83]
    v_min_f32 v73, s43, v73
    v_min_f32 v74, s43, v74
    v_mfma_f32_16x16x32_bf16 v[80:83], a[176:179], a[220:223], v[80:83]
    v_min_f32 v75, s43, v75
    v_mfma_f32_16x16x32_bf16 v[84:87], a[20:23], a[192:195], v[84:87]
    v_exp_f32 v72, v72
    v_mfma_f32_16x16x32_bf16 v[84:87], a[44:47], a[196:199], v[84:87]
    v_exp_f32 v73, v73
    v_mfma_f32_16x16x32_bf16 v[84:87], a[68:71], a[200:203], v[84:87]
    v_exp_f32 v74, v74
    v_mfma_f32_16x16x32_bf16 v[84:87], a[92:95], a[204:207], v[84:87]
    s_waitcnt lgkmcnt(1)
    buffer_store_dwordx4 v[48:51], v208, s[16:19], 0 offen offset:2048 sc1
    v_mul_f32 v80, s44, v80
    v_mfma_f32_16x16x32_bf16 v[84:87], a[116:119], a[208:211], v[84:87]
    v_exp_f32 v75, v75
    v_mfma_f32_16x16x32_bf16 v[84:87], a[140:143], a[212:215], v[84:87]
    v_add_f32 v244, 1.0, v72
    v_add_f32 v245, 1.0, v73
    v_mfma_f32_16x16x32_bf16 v[84:87], a[164:167], a[216:219], v[84:87]
    v_add_f32 v246, 1.0, v74
    v_add_f32 v247, 1.0, v75
    v_mfma_f32_16x16x32_bf16 v[84:87], a[188:191], a[220:223], v[84:87]
    v_mul_f32 v76, s46, v76
    v_mul_f32 v77, s46, v77
    v_mfma_f32_16x16x32_bf16 v[88:91], a[0:3], v[176:179], 0
    v_mul_f32 v78, s46, v78
    v_mul_f32 v79, s46, v79
    v_mfma_f32_16x16x32_bf16 v[88:91], a[24:27], v[180:183], v[88:91]
    v_exp_f32 v76, v76
    v_mfma_f32_16x16x32_bf16 v[88:91], a[48:51], v[184:187], v[88:91]
    v_exp_f32 v77, v77
    v_mfma_f32_16x16x32_bf16 v[88:91], a[72:75], v[188:191], v[88:91]
    v_exp_f32 v78, v78
    v_mfma_f32_16x16x32_bf16 v[88:91], a[96:99], v[192:195], v[88:91]
    v_exp_f32 v79, v79
    v_mfma_f32_16x16x32_bf16 v[88:91], a[120:123], v[196:199], v[88:91]
    v_fmac_f32 v244, v244, v76
    v_fmac_f32 v245, v245, v77
    v_mfma_f32_16x16x32_bf16 v[88:91], a[144:147], v[200:203], v[88:91]
    v_fmac_f32 v246, v246, v78
    v_fmac_f32 v247, v247, v79
    v_mfma_f32_16x16x32_bf16 v[88:91], a[168:171], v[204:207], v[88:91]
    v_rcp_f32 v76, v244
    v_mfma_f32_16x16x32_bf16 v[88:91], a[4:7], a[192:195], v[88:91]
    v_rcp_f32 v77, v245
    v_mfma_f32_16x16x32_bf16 v[88:91], a[28:31], a[196:199], v[88:91]
    v_rcp_f32 v78, v246
    v_mfma_f32_16x16x32_bf16 v[88:91], a[52:55], a[200:203], v[88:91]
    v_rcp_f32 v79, v247
    v_mfma_f32_16x16x32_bf16 v[88:91], a[76:79], a[204:207], v[88:91]
    v_fma_f32 v72, v72, v76, -v76
    v_fma_f32 v73, v73, v77, -v77
    v_mfma_f32_16x16x32_bf16 v[88:91], a[100:103], a[208:211], v[88:91]
    v_fma_f32 v74, v74, v78, -v78
    v_fma_f32 v75, v75, v79, -v79
    v_mfma_f32_16x16x32_bf16 v[88:91], a[124:127], a[212:215], v[88:91]
    v_cvt_pk_bf16_f32 v76, v72, v73
    v_cvt_pk_bf16_f32 v77, v74, v75
    v_mfma_f32_16x16x32_bf16 v[88:91], a[148:151], a[216:219], v[88:91]
    ds_write_b64 v11, v[76:77] offset:10240
    v_mul_f32 v81, s44, v81
    v_mfma_f32_16x16x32_bf16 v[88:91], a[172:175], a[220:223], v[88:91]
    ds_write_b32 v211, v219
    v_mul_f32 v82, s44, v82
    v_mfma_f32_16x16x32_bf16 v[88:91], a[8:11], a[224:227], v[88:91]
    v_mul_f32 v83, s44, v83
    v_min_f32 v80, s43, v80
    v_mfma_f32_16x16x32_bf16 v[88:91], a[32:35], a[228:231], v[88:91]
    v_min_f32 v81, s43, v81
    v_min_f32 v82, s43, v82
    v_mfma_f32_16x16x32_bf16 v[88:91], a[56:59], a[232:235], v[88:91]
    v_min_f32 v83, s43, v83
    v_mfma_f32_16x16x32_bf16 v[88:91], a[80:83], a[236:239], v[88:91]
    v_exp_f32 v80, v80
    v_mfma_f32_16x16x32_bf16 v[88:91], a[104:107], a[240:243], v[88:91]
    v_exp_f32 v81, v81
    v_mfma_f32_16x16x32_bf16 v[88:91], a[128:131], a[244:247], v[88:91]
    v_exp_f32 v82, v82
    v_mfma_f32_16x16x32_bf16 v[88:91], a[152:155], a[248:251], v[88:91]
    v_exp_f32 v83, v83
    v_mfma_f32_16x16x32_bf16 v[88:91], a[176:179], a[252:255], v[88:91]
    ds_read_b32 v222, v212
    v_add_f32 v248, 1.0, v80
    v_mfma_f32_16x16x32_bf16 v[92:95], a[12:15], v[176:179], 0
    ds_read_b128 v[64:67], v12 offset:8192
    v_add_f32 v249, 1.0, v81
    v_mfma_f32_16x16x32_bf16 v[92:95], a[36:39], v[180:183], v[92:95]
    v_add_f32 v250, 1.0, v82
    v_add_f32 v251, 1.0, v83
    v_mfma_f32_16x16x32_bf16 v[92:95], a[60:63], v[184:187], v[92:95]
    v_mul_f32 v84, s46, v84
    v_mul_f32 v85, s46, v85
    v_mfma_f32_16x16x32_bf16 v[92:95], a[84:87], v[188:191], v[92:95]
    v_mul_f32 v86, s46, v86
    v_mul_f32 v87, s46, v87
    v_mfma_f32_16x16x32_bf16 v[92:95], a[108:111], v[192:195], v[92:95]
    v_exp_f32 v84, v84
    v_mfma_f32_16x16x32_bf16 v[92:95], a[132:135], v[196:199], v[92:95]
    v_exp_f32 v85, v85
    v_mfma_f32_16x16x32_bf16 v[92:95], a[156:159], v[200:203], v[92:95]
    s_waitcnt lgkmcnt(0)
    buffer_store_dwordx4 v[64:67], v209, s[16:19], 0 offen offset:0 sc1
    v_mul_f32 v88, s44, v88
    v_mfma_f32_16x16x32_bf16 v[92:95], a[180:183], v[204:207], v[92:95]
    v_exp_f32 v86, v86
    v_mfma_f32_16x16x32_bf16 v[92:95], a[16:19], a[192:195], v[92:95]
    v_exp_f32 v87, v87
    v_mfma_f32_16x16x32_bf16 v[92:95], a[40:43], a[196:199], v[92:95]
    v_fmac_f32 v248, v248, v84
    v_fmac_f32 v249, v249, v85
    v_mfma_f32_16x16x32_bf16 v[92:95], a[64:67], a[200:203], v[92:95]
    v_fmac_f32 v250, v250, v86
    v_fmac_f32 v251, v251, v87
    v_mfma_f32_16x16x32_bf16 v[92:95], a[88:91], a[204:207], v[92:95]
    v_rcp_f32 v84, v248
    v_mfma_f32_16x16x32_bf16 v[92:95], a[112:115], a[208:211], v[92:95]
    v_rcp_f32 v85, v249
    v_mfma_f32_16x16x32_bf16 v[92:95], a[136:139], a[212:215], v[92:95]
    v_rcp_f32 v86, v250
    v_mfma_f32_16x16x32_bf16 v[92:95], a[160:163], a[216:219], v[92:95]
    v_rcp_f32 v87, v251
    v_mfma_f32_16x16x32_bf16 v[92:95], a[184:187], a[220:223], v[92:95]
    v_fma_f32 v80, v80, v84, -v84
    v_fma_f32 v81, v81, v85, -v85
    v_mfma_f32_16x16x32_bf16 v[92:95], a[20:23], a[224:227], v[92:95]
    v_fma_f32 v82, v82, v86, -v86
    v_fma_f32 v83, v83, v87, -v87
    v_mfma_f32_16x16x32_bf16 v[92:95], a[44:47], a[228:231], v[92:95]
    v_cvt_pk_bf16_f32 v84, v80, v81
    v_cvt_pk_bf16_f32 v85, v82, v83
    v_mfma_f32_16x16x32_bf16 v[92:95], a[68:71], a[232:235], v[92:95]
    ds_write_b64 v11, v[84:85] offset:12288
    v_mul_f32 v89, s44, v89
    v_mfma_f32_16x16x32_bf16 v[92:95], a[92:95], a[236:239], v[92:95]
    v_mul_f32 v90, s44, v90
    v_mul_f32 v91, s44, v91
    v_mfma_f32_16x16x32_bf16 v[92:95], a[116:119], a[240:243], v[92:95]
    v_min_f32 v88, s43, v88
    v_min_f32 v89, s43, v89
    v_mfma_f32_16x16x32_bf16 v[92:95], a[140:143], a[244:247], v[92:95]
    v_min_f32 v90, s43, v90
    v_min_f32 v91, s43, v91
    v_mfma_f32_16x16x32_bf16 v[92:95], a[164:167], a[248:251], v[92:95]
    v_exp_f32 v88, v88
    v_mfma_f32_16x16x32_bf16 v[92:95], a[188:191], a[252:255], v[92:95]
    v_exp_f32 v89, v89
    v_exp_f32 v90, v90
    v_exp_f32 v91, v91
    v_pk_add_f32 v[252:253], v[88:89], 1.0 op_sel_hi:[1,0]
    v_pk_add_f32 v[254:255], v[90:91], 1.0 op_sel_hi:[1,0]
    s_nop 2
    v_pk_mul_f32 v[92:93], v[92:93], s[46:47]
    v_pk_mul_f32 v[94:95], v[94:95], s[46:47]
    v_exp_f32 v92, v92
    v_exp_f32 v93, v93
    v_exp_f32 v94, v94
    v_exp_f32 v95, v95
    v_pk_fma_f32 v[252:253], v[252:253], v[92:93], v[252:253]
    v_pk_fma_f32 v[254:255], v[254:255], v[94:95], v[254:255]
    v_rcp_f32 v92, v252
    v_rcp_f32 v93, v253
    v_rcp_f32 v94, v254
    v_rcp_f32 v95, v255
    v_pk_fma_f32 v[88:89], v[88:89], v[92:93], v[92:93] neg_lo:[0,0,1] neg_hi:[0,0,1]
    v_pk_fma_f32 v[90:91], v[90:91], v[94:95], v[94:95] neg_lo:[0,0,1] neg_hi:[0,0,1]
    v_cvt_pk_bf16_f32 v92, v88, v89
    v_cvt_pk_bf16_f32 v93, v90, v91
    ds_write_b64 v11, v[92:93] offset:14336
    s_waitcnt lgkmcnt(0)
    s_barrier
    ds_read_b128 v[80:83], v12 offset:12288
    v_subrev_u32 v220, 1, v220
    v_subrev_u32 v221, 2, v221
    v_or_b32 v220, v220, v221
    v_subrev_u32 v222, 3, v222
    v_or_b32 v220, v220, v222
    v_cmp_gt_i32 vcc, 0, v220
    s_waitcnt lgkmcnt(0)
    buffer_store_dwordx4 v[80:83], v210, s[16:19], 0 offen offset:0 sc1
    s_cbranch_vccnz L_redo
L_done:
    s_endpgm
L_redo:
    s_waitcnt vmcnt(0)
    ds_read_b128 v[32:35], v12 offset:0
    ds_read_b128 v[48:51], v12 offset:4096
    ds_read_b128 v[64:67], v12 offset:8192
    s_waitcnt lgkmcnt(0)
    buffer_store_dwordx4 v[32:35], v208, s[16:19], 0 offen offset:0 sc1
    buffer_store_dwordx4 v[48:51], v208, s[16:19], 0 offen offset:2048 sc1
    buffer_store_dwordx4 v[64:67], v209, s[16:19], 0 offen offset:0 sc1
L_end:
    s_endpgm
.section .rodata,"a"
.p2align 6
.amdhsa_kernel standalone__autoregressive_conv_wavernn__speech_kernel
  .amdhsa_next_free_vgpr 512
  .amdhsa_next_free_sgpr 102
  .amdhsa_accum_offset 256
  .amdhsa_group_segment_fixed_size 0
  .amdhsa_kernarg_size 40
  .amdhsa_user_sgpr_count 2
  .amdhsa_user_sgpr_kernarg_segment_ptr 1
  .amdhsa_system_sgpr_workgroup_id_x 1
.end_amdhsa_kernel
```
